```python
import torch

def _softmax(x, axis=-1):
    return torch.softmax(x, dim=axis)
def _gelu(x):
    return torch.nn.functional.gelu(x, approximate="tanh")
def _silu(x):
    return torch.nn.functional.silu(x)
def _sigmoid(x):
    return torch.sigmoid(x)
def _layernorm(x, axis=-1, eps=1e-5):
    m = x.mean(dim=axis, keepdim=True)
    v = x.var(dim=axis, keepdim=True, unbiased=False)
    return (x - m) / torch.sqrt(v + eps)
def _scatter_add(tgt, idx, src, axis=0):
    return tgt.clone().index_add_(axis, idx, src)
def _segment_sum(src, seg, n):
    out = torch.zeros((n,) + src.shape[1:], dtype=src.dtype)
    return out.index_add_(0, seg, src)
def _pad(x, pw):
    flat = tuple(v for pair in reversed(pw) for v in pair)
    return torch.nn.functional.pad(x, flat)

kernel_name = 'standalone__sequential_behavior_din__recsys'

def setup_inputs():

    _w = (lambda a: (lambda t: t.to(torch.bfloat16) if t.is_floating_point() else t)(torch.as_tensor(a)))
    B, L, D = 4096, 50, 64
    H = D
    return {
        "target": _w((lambda *s: torch.randn(*s, dtype=torch.bfloat16) * 3.2)(B, D)),
        "hist": _w((lambda *s: torch.randn(*s, dtype=torch.bfloat16) * 3.2)(B, L, D)),
        "mask": _w((lambda lo, hi, *s: torch.randint(lo, hi, s))(0, 2, B, L).to(float)),
        "w1": _w((lambda *s: torch.randn(*s, dtype=torch.bfloat16) * 3.2)(4 * D, H) * (4 * D) ** -0.5),
        "b1": _w((lambda *s: torch.randn(*s, dtype=torch.bfloat16) * 3.2)(H) * 0.1),
        "w2": _w((lambda *s: torch.randn(*s, dtype=torch.bfloat16) * 0.05)(H, 1) * H ** -0.5),
        "b2": _w((lambda *s: torch.randn(*s, dtype=torch.bfloat16) * 0.05)(1) * 0.1),
    }

def reference(target, hist, mask, w1, b1, w2, b2):
    L = hist.shape[1]
    tgt = (lambda x, n, axis: torch.repeat_interleave(x, n, dim=axis))(target[:, None, :], L, axis=1)
    feat = torch.concatenate([hist, tgt, hist - tgt, hist * tgt], axis=-1)
    h = _sigmoid(feat @ w1 + b1)
    scores = (h @ w2 + b2)[..., 0] * mask
    return torch.einsum('bl,bld->bd', scores, hist)
```

```asm
; @launch grid=(256,1,1) block=(512,1,1) lds=159232
.amdgcn_target "amdgcn-amd-amdhsa--gfx950"
.text
.globl standalone__sequential_behavior_din__recsys_kernel
.p2align 8
.type standalone__sequential_behavior_din__recsys_kernel,@function
standalone__sequential_behavior_din__recsys_kernel:
    s_cmp_ge_u32 s2, 256
    s_cbranch_scc1 L_end
    s_load_dwordx16 s[4:19], s[0:1], 0
    v_lshrrev_b32 v27, 6, v0
    v_and_b32 v184, 63, v0
    v_readfirstlane_b32 s24, v27
    v_and_b32 v1, 15, v0
    v_lshrrev_b32 v185, 4, v184
    v_lshlrev_b32 v190, 2, v184
    v_mov_b32 v186, 0
    v_and_b32 v28, 1, v184
    v_lshlrev_b32 v28, 4, v28
    v_lshl_add_u32 v2, v185, 5, v28
    v_lshrrev_b32 v192, 1, v1
    s_lshr_b32 s28, s24, 1
    s_xor_b32 s28, s28, s24
    s_and_b32 s28, s28, 1
    s_lshl_b32 s28, s28, 2
    v_xor_b32 v28, s28, v192
    v_lshl_add_u32 v193, v28, 7, v2
    s_lshl_b32 s25, s2, 4
    s_lshl_b32 s28, s24, 1
    s_add_u32 s25, s25, s28
    s_lshl_b32 s29, s24, 10
    s_mul_i32 s28, s25, 100
    s_lshl_b32 s30, s25, 7
    s_lshr_b32 s26, s24, 2
    s_and_b32 s27, s24, 3
    s_mul_i32 s55, s24, 1280
    s_add_u32 s55, s55, 148992
    s_mul_i32 s56, s24, 10240
    s_lshl_b32 s57, s24, 12
    s_add_u32 s57, s57, 81920
    v_mov_b32 v180, 0
    v_mov_b32 v181, 0
    v_mov_b32 v182, 0
    v_mov_b32 v183, 0
    v_lshlrev_b32 v191, 4, v184
    v_add_u32 v27, s55, v191
    v_add_u32 v28, s55, v190
    s_mov_b32 m0, 109568
    s_cmp_lg_u32 s24, 7
    s_waitcnt lgkmcnt(0)
    s_cbranch_scc1 L_nowv
    s_mov_b32 exec_hi, 0
    global_load_lds_dword v190, s[14:15]
    s_mov_b32 m0, 109696
    s_nop 0
    global_load_lds_dword v190, s[12:13]
    s_mov_b32 exec_hi, -1
L_nowv:
    s_add_u32 s32, s8, s28
    s_addc_u32 s33, s9, 0
    s_mov_b32 exec_hi, 0x3ffff
    global_load_dword v186, v190, s[32:33]
    s_mov_b32 exec_hi, -1
    s_add_u32 s34, s4, s30
    s_addc_u32 s35, s5, 0
    global_load_dword v187, v190, s[34:35]
    s_add_u32 s36, s10, s29
    s_addc_u32 s37, s11, 0
    s_add_u32 m0, s29, 81920
    s_nop 0
    global_load_lds_dwordx4 v193, s[36:37]
    s_add_u32 s36, s36, 8192
    s_addc_u32 s37, s37, 0
    s_add_u32 m0, m0, 8192
    s_nop 0
    global_load_lds_dwordx4 v193, s[36:37]
    s_add_u32 s36, s36, 8192
    s_addc_u32 s37, s37, 0
    s_add_u32 m0, m0, 8192
    s_nop 0
    global_load_lds_dwordx4 v193, s[36:37]
    s_add_u32 s36, s36, 8192
    s_addc_u32 s37, s37, 0
    s_add_u32 m0, m0, 16384
    s_nop 0
    global_load_lds_dwordx4 v193, s[36:37]
    s_load_dword s31, s[16:17], 0
    ds_write_b128 v27, v[180:183]
    ds_write_b32 v28, v180 offset:1024
    s_add_u32 s38, s18, s30
    s_addc_u32 s39, s19, 0
    s_mul_i32 s30, s25, 6400
    s_mov_b32 s20, s6
    s_and_b32 s21, s7, 0xffff
    s_mov_b32 s22, 26214400
    s_mov_b32 s23, 0x00020000
    v_lshl_add_u32 v8, v192, 1, s55
    v_lshlrev_b32 v195, 8, v184
    v_cmp_lt_u32 vcc, 24, v184
    v_mov_b32 v28, 448
    v_lshlrev_b32 v194, 3, v185
    v_cndmask_b32 v196, 0, v28, vcc
    v_add_u32 v196, s55, v196
    v_add_u32 v202, 128, v195
    s_lshl_b32 s28, s24, 7
    s_add_u32 s28, s28, 147968
    v_add_u32 v27, s28, v190
    s_mov_b32 exec_hi, 0
    ds_write_b32 v27, v180
    s_mov_b32 exec_hi, -1
    v_lshrrev_b32 v208, 1, v185
    v_and_b32 v207, 1, v185
    v_lshlrev_b32 v209, 3, v1
    s_add_u32 s28, s56, 6144
    v_add_u32 v204, s28, v190
    v_lshl_add_u32 v27, v208, 8, s28
    v_lshrrev_b32 v28, 2, v1
    v_lshl_add_u32 v27, v28, 4, v27
    v_bfe_u32 v28, v1, 1, 1
    v_lshl_add_u32 v23, v28, 2, v27
    s_mul_i32 s28, s24, 320
    s_add_u32 s28, s28, 106496
    v_mad_u32_u24 v197, v208, 32, v190
    v_add_u32 v197, s28, v197
    v_lshrrev_b32 v28, 3, v1
    v_cmp_eq_u32 vcc, v28, v207
    v_and_b32 v200, 1, v1
    v_lshlrev_b32 v200, 4, v200
    v_mov_b32 v201, 0xffff
    v_lshlrev_b32 v200, v200, v201
    v_cndmask_b32 v200, 0, v200, vcc
    v_bfe_u32 v201, v1, 1, 2
    v_cmp_gt_u32 s[44:45], 2, v185
    v_mov_b32 v27, 0x3b2c3b2c
    v_mov_b32 v203, 0xbfb9bfb9
    v_cndmask_b32 v27, v27, v203, s[44:45]
    v_cmp_eq_u32 vcc, 0, v201
    s_nop 1
    v_cndmask_b32 v40, 0, v200, vcc
    v_cmp_eq_u32 vcc, 1, v201
    s_nop 1
    v_cndmask_b32 v41, 0, v200, vcc
    v_cmp_eq_u32 vcc, 2, v201
    s_nop 1
    v_cndmask_b32 v42, 0, v200, vcc
    v_cmp_eq_u32 vcc, 3, v201
    s_nop 1
    v_cndmask_b32 v43, 0, v200, vcc
    v_and_b32 v44, v27, v40
    v_and_b32 v45, v27, v41
    v_and_b32 v46, v27, v42
    v_and_b32 v47, v27, v43
    v_mul_u32_u24 v200, 448, v28
    v_lshl_add_u32 v200, v185, 4, v200
    v_add_u32 v7, s55, v200
    v_lshl_add_u32 v9, v28, 7, v194
    v_and_b32 v200, 3, v1
    v_lshl_add_u32 v9, v200, 5, v9
    v_cmp_eq_u32 s[46:47], 1, v200
    v_cmp_eq_u32 s[48:49], 2, v200
    v_cmp_eq_u32 s[50:51], 3, v200
    v_lshlrev_b32 v200, 8, v208
    v_lshl_add_u32 v200, v207, 4, v200
    v_and_b32 v201, 7, v1
    v_lshl_add_u32 v200, v201, 5, v200
    v_add_u32 v5, 147968, v200
    v_lshl_add_u32 v4, v28, 10, v200
    v_lshl_add_u32 v27, v207, 11, v209
    v_lshl_add_u32 v27, v207, 7, v27
    s_lshl_b32 s28, s26, 12
    s_lshl_b32 s29, s27, 8
    s_add_u32 s28, s28, s29
    s_add_u32 s28, s28, 81920
    v_add_u32 v16, s28, v27
    v_xor_b32 v17, 128, v16
    v_add_u32 v11, 114688, v27
    v_xor_b32 v12, 128, v11
    v_xor_b32 v27, v208, v207
    v_lshl_add_u32 v27, v27, 7, v209
    v_lshl_add_u32 v27, v185, 10, v27
    v_add_u32 v18, s28, v27
    v_xor_b32 v19, 128, v18
    s_lshl_b32 s28, s26, 6
    s_add_u32 s28, s28, 106496
    v_lshl_add_u32 v27, v185, 4, s28
    v_mul_u32_u24 v20, 160, v1
    v_add_u32 v20, v20, v27
    v_add_u32 v10, 122880, v191
    s_lshl_b32 s28, s26, 13
    s_lshl_b32 s29, s27, 10
    s_add_u32 s28, s28, s29
    v_add_u32 v21, s28, v10
    s_mul_i32 s28, s26, 4352
    s_lshl_b32 s29, s27, 6
    s_add_u32 s28, s28, s29
    s_add_u32 s28, s28, 139264
    v_lshl_add_u32 v22, v185, 4, s28
    v_mul_u32_u24 v27, 272, v1
    v_add_u32 v22, v22, v27
    s_mul_i32 s28, s24, 544
    s_add_u32 s28, s28, 139264
    v_lshl_add_u32 v24, v184, 3, s28
    v_lshl_add_u32 v24, v208, 4, v24
    v_lshl_add_u32 v3, v185, 4, s28
    v_add_u32 v25, 109568, v194
    v_and_b32 v26, 124, v190
    v_add_u32 v26, 109696, v26
    v_lshl_add_u32 v6, v207, 7, v209
    v_lshl_add_u32 v6, v208, 10, v6
    v_mfma_f32_16x16x16_bf16 v[120:123], v[180:181], v[180:181], 0
    v_mfma_f32_16x16x16_bf16 v[124:127], v[180:181], v[180:181], 0
    v_mfma_f32_16x16x16_bf16 v[128:131], v[180:181], v[180:181], 0
    v_mfma_f32_16x16x16_bf16 v[132:135], v[180:181], v[180:181], 0
    s_waitcnt vmcnt(5)
    v_lshlrev_b32 v188, 16, v186
    v_and_b32 v189, 0xffff0000, v186
    v_cmp_neq_f32 s[40:41], 0, v188
    v_cmp_neq_f32 s[42:43], 0, v189
    s_mov_b32 m0, s56
    v_mbcnt_lo_u32_b32 v198, s40, 0
    v_mbcnt_hi_u32_b32 v198, s41, v198
    v_mbcnt_lo_u32_b32 v198, s42, v198
    v_mbcnt_hi_u32_b32 v198, s43, v198
    v_addc_co_u32 v199, vcc, v198, 0, s[40:41]
    v_lshl_add_u32 v200, v198, 1, s55
    v_lshl_add_u32 v201, v199, 1, s55
    s_mov_b64 exec, s[40:41]
    ds_write_b16 v200, v195 offset:1024
    s_mov_b64 exec, s[42:43]
    ds_write_b16 v201, v202 offset:1024
    s_mov_b64 exec, -1
    ds_read_u16 v29, v8 offset:1024
    ds_read_u16 v30, v8 offset:1040
    ds_read_u16 v31, v8 offset:1056
    ds_read_u16 v32, v8 offset:1072
    ds_read_u16 v33, v8 offset:1088
    ds_read_u16 v34, v8 offset:1104
    v_lshl_add_u32 v200, v198, 2, v196
    v_lshl_add_u32 v201, v199, 2, v196
    s_mov_b64 exec, s[40:41]
    ds_write_b32 v200, v188
    s_mov_b64 exec, s[42:43]
    ds_write_b32 v201, v189
    s_mov_b64 exec, -1
    s_waitcnt lgkmcnt(7)
    v_add_u32 v29, v29, v2
    buffer_load_dwordx4 v29, s[20:23], s30 offen nt lds
    s_add_u32 m0, m0, 1024
    s_waitcnt lgkmcnt(6)
    v_add_u32 v30, v30, v2
    buffer_load_dwordx4 v30, s[20:23], s30 offen nt lds
    s_add_u32 m0, m0, 1024
    s_waitcnt vmcnt(6)
    ds_write_b32 v197, v187
    v_lshlrev_b32 v200, 16, v187
    v_and_b32 v201, 0xffff0000, v187
    v_mul_f32 v200, 0xbfb8aa3b, v200
    v_mul_f32 v201, 0xbfb8aa3b, v201
    v_cvt_pk_bf16_f32 v205, v200, v201
    v_lshlrev_b32 v202, 16, v205
    v_and_b32 v203, 0xffff0000, v205
    v_sub_f32 v200, v200, v202
    v_sub_f32 v201, v201, v203
    v_cvt_pk_bf16_f32 v206, v200, v201
    ds_write_b32 v204, v205
    ds_write_b32 v204, v206 offset:256
    ds_read2_b32 v[172:173], v23 offset0:0 offset1:2
    ds_read2_b32 v[174:175], v23 offset0:16 offset1:18
    ds_read2_b32 v[176:177], v23 offset0:32 offset1:34
    ds_read2_b32 v[178:179], v23 offset0:48 offset1:50
    s_waitcnt lgkmcnt(9)
    v_add_u32 v31, v31, v2
    v_add_u32 v32, v32, v2
    v_add_u32 v33, v33, v2
    v_add_u32 v34, v34, v2
    s_and_b32 s28, s40, 0x1ffffff
    s_and_b32 s29, s42, 0x1ffffff
    s_bcnt1_i32_b32 s52, s28
    s_bcnt1_i32_b32 s29, s29
    s_add_u32 s52, s52, s29
    s_bcnt1_i32_b64 s53, s[40:41]
    s_bcnt1_i32_b64 s29, s[42:43]
    s_add_u32 s53, s53, s29
    s_add_u32 s53, s53, 15
    s_lshr_b32 s53, s53, 4
    s_max_u32 s54, s53, 3
    s_sub_u32 s54, s54, 1
    s_waitcnt lgkmcnt(0)
    v_and_b32 v140, v172, v40
    v_and_b32 v141, v172, v41
    v_and_b32 v142, v172, v42
    v_and_b32 v143, v172, v43
    v_and_b32 v156, v176, v40
    v_and_b32 v157, v176, v41
    v_and_b32 v158, v176, v42
    v_and_b32 v159, v176, v43
    v_and_b32 v144, v173, v40
    v_and_b32 v145, v173, v41
    v_and_b32 v146, v173, v42
    v_and_b32 v147, v173, v43
    v_and_b32 v160, v177, v40
    v_and_b32 v161, v177, v41
    v_and_b32 v162, v177, v42
    v_and_b32 v163, v177, v43
    v_and_b32 v148, v174, v40
    v_and_b32 v149, v174, v41
    v_and_b32 v150, v174, v42
    v_and_b32 v151, v174, v43
    v_and_b32 v164, v178, v40
    v_and_b32 v165, v178, v41
    v_and_b32 v166, v178, v42
    v_and_b32 v167, v178, v43
    v_and_b32 v152, v175, v40
    v_and_b32 v153, v175, v41
    v_and_b32 v154, v175, v42
    v_and_b32 v155, v175, v43
    v_and_b32 v168, v179, v40
    v_and_b32 v169, v179, v41
    v_and_b32 v170, v179, v42
    v_and_b32 v171, v179, v43
    s_waitcnt vmcnt(2) lgkmcnt(0)
    s_barrier
    ds_read_b128 v[216:219], v20
    ds_read_b64_tr_b16 v[180:181], v18 offset:8192
    ds_read_b64_tr_b16 v[182:183], v19 offset:8192
    ds_read_b64_tr_b16 v[184:185], v18 offset:16384
    ds_read_b64_tr_b16 v[186:187], v19 offset:16384
    ds_read_b64_tr_b16 v[188:189], v16 offset:0
    ds_read_b64_tr_b16 v[190:191], v17 offset:1024
    ds_read_b64_tr_b16 v[192:193], v16 offset:16384
    ds_read_b64_tr_b16 v[194:195], v17 offset:17408
    ds_read_b64_tr_b16 v[200:201], v17 offset:0
    ds_read_b64_tr_b16 v[202:203], v16 offset:1024
    ds_read_b64_tr_b16 v[208:209], v17 offset:16384
    ds_read_b64_tr_b16 v[210:211], v16 offset:17408
    ds_read_b64 v[112:113], v25 offset:0
    ds_read_b64 v[114:115], v25 offset:32
    ds_read_b64 v[116:117], v25 offset:64
    ds_read_b64 v[118:119], v25 offset:96
    ds_read_b32 v26, v26
    buffer_load_dwordx4 v31, s[20:23], s30 offen nt lds
    s_add_u32 m0, m0, 1024
    s_lshl_b32 s31, s31, 16
    s_mov_b32 s28, 0x80008000
    s_waitcnt lgkmcnt(13)
    v_xor_b32 v224, s28, v216
    v_xor_b32 v225, s28, v217
    v_xor_b32 v226, s28, v218
    v_xor_b32 v227, s28, v219
    v_mfma_f32_16x16x32_bf16 v[236:239], v[180:183], v[216:219], 0
    s_nop 0
    v_mfma_f32_16x16x32_bf16 v[236:239], v[184:187], v[224:227], v[236:239]
    s_waitcnt lgkmcnt(9)
    v_mfma_f32_16x16x32_bf16 v[228:231], v[44:47], v[188:191], 0
    v_mfma_f32_16x16x32_bf16 v[228:231], v[44:47], v[192:195], v[228:231]
    s_waitcnt lgkmcnt(5)
    v_mfma_f32_16x16x32_bf16 v[232:235], v[44:47], v[200:203], 0
    v_mfma_f32_16x16x32_bf16 v[232:235], v[44:47], v[208:211], v[232:235]
    s_nop 1
    ds_write_b128 v22, v[236:239]
    s_nop 1
    ds_write_b128 v21, v[228:231]
    s_nop 1
    ds_write_b128 v21, v[232:235] offset:4096
    ds_read_b64_tr_b16 v[196:197], v11 offset:0
    ds_read_b64_tr_b16 v[198:199], v12 offset:1024
    ds_read_b64_tr_b16 v[204:205], v11 offset:256
    ds_read_b64_tr_b16 v[206:207], v12 offset:1280
    ds_read_b64_tr_b16 v[212:213], v11 offset:512
    ds_read_b64_tr_b16 v[214:215], v12 offset:1536
    ds_read_b64_tr_b16 v[220:221], v11 offset:768
    ds_read_b64_tr_b16 v[222:223], v12 offset:1792
    buffer_load_dwordx4 v32, s[20:23], s30 offen nt lds
    s_add_u32 m0, m0, 1024
    v_mov_b32 v136, s31
    v_mov_b32 v137, s31
    v_mov_b32 v138, s31
    v_mov_b32 v139, s31
    s_waitcnt lgkmcnt(8)
    s_barrier
    ds_read_b128 v[200:203], v10 offset:0
    ds_read_b128 v[208:211], v10 offset:1024
    ds_read_b128 v[216:219], v10 offset:2048
    ds_read_b128 v[224:227], v10 offset:3072
    ds_read_b64 v[244:245], v24
    ds_read_b64 v[246:247], v24 offset:4352
    buffer_load_dwordx4 v33, s[20:23], s30 offen nt lds
    s_add_u32 m0, m0, 1024
    s_waitcnt lgkmcnt(5)
    v_mfma_f32_16x16x32_bf16 v[172:175], v[140:143], v[196:199], v[200:203]
    v_mfma_f32_16x16x32_bf16 v[176:179], v[156:159], v[196:199], v[200:203]
    ds_read_b64_tr_b16 v[228:229], v12 offset:0
    ds_read_b64_tr_b16 v[230:231], v11 offset:1024
    ds_read_b128 v[232:235], v10 offset:4096
    s_waitcnt lgkmcnt(7)
    v_mfma_f32_16x16x32_bf16 v[180:183], v[140:143], v[204:207], v[208:211]
    v_mfma_f32_16x16x32_bf16 v[184:187], v[156:159], v[204:207], v[208:211]
    ds_read_b64_tr_b16 v[196:197], v12 offset:256
    ds_read_b64_tr_b16 v[198:199], v11 offset:1280
    ds_read_b128 v[200:203], v10 offset:5120
    buffer_load_dwordx4 v34, s[20:23], s30 offen nt lds
    s_waitcnt lgkmcnt(6)
    v_lshlrev_b32 v27, 16, v26
    v_and_b32 v28, 0xffff0000, v26
    v_add_f32 v244, v244, v246
    v_add_f32 v245, v245, v247
    v_add_f32 v244, v244, v27
    v_add_f32 v245, v245, v28
    v_mul_f32 v244, 0xbfb8aa3b, v244
    v_mul_f32 v245, 0xbfb8aa3b, v245
    ds_write_b64 v24, v[244:245]
    v_cvt_pk_bf16_f32 v48, v172, v173
    v_cvt_pk_bf16_f32 v49, v174, v175
    v_cvt_pk_bf16_f32 v80, v176, v177
    v_cvt_pk_bf16_f32 v81, v178, v179
    s_waitcnt lgkmcnt(10)
    v_mfma_f32_16x16x32_bf16 v[188:191], v[140:143], v[212:215], v[216:219]
    v_mfma_f32_16x16x32_bf16 v[192:195], v[156:159], v[212:215], v[216:219]
    ds_read_b64_tr_b16 v[204:205], v12 offset:512
    ds_read_b64_tr_b16 v[206:207], v11 offset:1536
    ds_read_b128 v[208:211], v10 offset:6144
    v_cvt_pk_bf16_f32 v56, v180, v181
    v_cvt_pk_bf16_f32 v57, v182, v183
    v_cvt_pk_bf16_f32 v88, v184, v185
    v_cvt_pk_bf16_f32 v89, v186, v187
    s_waitcnt lgkmcnt(12)
    v_mfma_f32_16x16x32_bf16 v[172:175], v[140:143], v[220:223], v[224:227]
    v_mfma_f32_16x16x32_bf16 v[176:179], v[156:159], v[220:223], v[224:227]
    ds_read_b64_tr_b16 v[212:213], v12 offset:768
    ds_read_b64_tr_b16 v[214:215], v11 offset:1792
    ds_read_b128 v[216:219], v10 offset:7168
    v_cvt_pk_bf16_f32 v64, v188, v189
    v_cvt_pk_bf16_f32 v65, v190, v191
    v_cvt_pk_bf16_f32 v96, v192, v193
    v_cvt_pk_bf16_f32 v97, v194, v195
    s_waitcnt lgkmcnt(10)
    v_mfma_f32_16x16x32_bf16 v[180:183], v[144:147], v[228:231], v[232:235]
    v_mfma_f32_16x16x32_bf16 v[184:187], v[160:163], v[228:231], v[232:235]
    ds_read_b64_tr_b16 v[220:221], v11 offset:4096
    ds_read_b64_tr_b16 v[222:223], v12 offset:5120
    ds_read_b128 v[224:227], v10 offset:8192
    v_cvt_pk_bf16_f32 v72, v172, v173
    v_cvt_pk_bf16_f32 v73, v174, v175
    v_cvt_pk_bf16_f32 v104, v176, v177
    v_cvt_pk_bf16_f32 v105, v178, v179
    s_waitcnt lgkmcnt(10)
    v_mfma_f32_16x16x32_bf16 v[188:191], v[144:147], v[196:199], v[200:203]
    v_mfma_f32_16x16x32_bf16 v[192:195], v[160:163], v[196:199], v[200:203]
    ds_read_b64_tr_b16 v[228:229], v11 offset:4352
    ds_read_b64_tr_b16 v[230:231], v12 offset:5376
    ds_read_b128 v[232:235], v10 offset:9216
    v_cvt_pk_bf16_f32 v50, v180, v181
    v_cvt_pk_bf16_f32 v51, v182, v183
    v_cvt_pk_bf16_f32 v82, v184, v185
    v_cvt_pk_bf16_f32 v83, v186, v187
    s_waitcnt lgkmcnt(9)
    v_mfma_f32_16x16x32_bf16 v[172:175], v[144:147], v[204:207], v[208:211]
    v_mfma_f32_16x16x32_bf16 v[176:179], v[160:163], v[204:207], v[208:211]
    ds_read_b64_tr_b16 v[196:197], v11 offset:4608
    ds_read_b64_tr_b16 v[198:199], v12 offset:5632
    ds_read_b128 v[200:203], v10 offset:10240
    v_cvt_pk_bf16_f32 v58, v188, v189
    v_cvt_pk_bf16_f32 v59, v190, v191
    v_cvt_pk_bf16_f32 v90, v192, v193
    v_cvt_pk_bf16_f32 v91, v194, v195
    s_waitcnt lgkmcnt(9)
    v_mfma_f32_16x16x32_bf16 v[180:183], v[144:147], v[212:215], v[216:219]
    v_mfma_f32_16x16x32_bf16 v[184:187], v[160:163], v[212:215], v[216:219]
    ds_read_b64_tr_b16 v[204:205], v11 offset:4864
    ds_read_b64_tr_b16 v[206:207], v12 offset:5888
    ds_read_b128 v[208:211], v10 offset:11264
    v_cvt_pk_bf16_f32 v66, v172, v173
    v_cvt_pk_bf16_f32 v67, v174, v175
    v_cvt_pk_bf16_f32 v98, v176, v177
    v_cvt_pk_bf16_f32 v99, v178, v179
    s_waitcnt lgkmcnt(9)
    v_mfma_f32_16x16x32_bf16 v[188:191], v[148:151], v[220:223], v[224:227]
    v_mfma_f32_16x16x32_bf16 v[192:195], v[164:167], v[220:223], v[224:227]
    ds_read_b64_tr_b16 v[212:213], v12 offset:4096
    ds_read_b64_tr_b16 v[214:215], v11 offset:5120
    ds_read_b128 v[216:219], v10 offset:12288
    v_cvt_pk_bf16_f32 v74, v180, v181
    v_cvt_pk_bf16_f32 v75, v182, v183
    v_cvt_pk_bf16_f32 v106, v184, v185
    v_cvt_pk_bf16_f32 v107, v186, v187
    s_waitcnt lgkmcnt(9)
    v_mfma_f32_16x16x32_bf16 v[172:175], v[148:151], v[228:231], v[232:235]
    v_mfma_f32_16x16x32_bf16 v[176:179], v[164:167], v[228:231], v[232:235]
    ds_read_b64_tr_b16 v[220:221], v12 offset:4352
    ds_read_b64_tr_b16 v[222:223], v11 offset:5376
    ds_read_b128 v[224:227], v10 offset:13312
    v_cvt_pk_bf16_f32 v52, v188, v189
    v_cvt_pk_bf16_f32 v53, v190, v191
    v_cvt_pk_bf16_f32 v84, v192, v193
    v_cvt_pk_bf16_f32 v85, v194, v195
    s_waitcnt lgkmcnt(9)
    v_mfma_f32_16x16x32_bf16 v[180:183], v[148:151], v[196:199], v[200:203]
    v_mfma_f32_16x16x32_bf16 v[184:187], v[164:167], v[196:199], v[200:203]
    ds_read_b64_tr_b16 v[228:229], v12 offset:4608
    ds_read_b64_tr_b16 v[230:231], v11 offset:5632
    ds_read_b128 v[232:235], v10 offset:14336
    v_cvt_pk_bf16_f32 v60, v172, v173
    v_cvt_pk_bf16_f32 v61, v174, v175
    v_cvt_pk_bf16_f32 v92, v176, v177
    v_cvt_pk_bf16_f32 v93, v178, v179
    s_waitcnt lgkmcnt(9)
    v_mfma_f32_16x16x32_bf16 v[188:191], v[148:151], v[204:207], v[208:211]
    v_mfma_f32_16x16x32_bf16 v[192:195], v[164:167], v[204:207], v[208:211]
    ds_read_b64_tr_b16 v[196:197], v12 offset:4864
    ds_read_b64_tr_b16 v[198:199], v11 offset:5888
    ds_read_b128 v[200:203], v10 offset:15360
    v_cvt_pk_bf16_f32 v68, v180, v181
    v_cvt_pk_bf16_f32 v69, v182, v183
    v_cvt_pk_bf16_f32 v100, v184, v185
    v_cvt_pk_bf16_f32 v101, v186, v187
    s_waitcnt lgkmcnt(9)
    v_mfma_f32_16x16x32_bf16 v[172:175], v[152:155], v[212:215], v[216:219]
    v_mfma_f32_16x16x32_bf16 v[176:179], v[168:171], v[212:215], v[216:219]
    v_cvt_pk_bf16_f32 v76, v188, v189
    v_cvt_pk_bf16_f32 v77, v190, v191
    v_cvt_pk_bf16_f32 v108, v192, v193
    v_cvt_pk_bf16_f32 v109, v194, v195
    s_waitcnt lgkmcnt(6)
    v_mfma_f32_16x16x32_bf16 v[180:183], v[152:155], v[220:223], v[224:227]
    v_mfma_f32_16x16x32_bf16 v[184:187], v[168:171], v[220:223], v[224:227]
    v_cvt_pk_bf16_f32 v54, v172, v173
    v_cvt_pk_bf16_f32 v55, v174, v175
    v_cvt_pk_bf16_f32 v86, v176, v177
    v_cvt_pk_bf16_f32 v87, v178, v179
    s_waitcnt lgkmcnt(3)
    v_mfma_f32_16x16x32_bf16 v[188:191], v[152:155], v[228:231], v[232:235]
    v_mfma_f32_16x16x32_bf16 v[192:195], v[168:171], v[228:231], v[232:235]
    ds_read_b128 v[204:207], v3 offset:0
    ds_read_b128 v[208:211], v3 offset:64
    ds_read_b128 v[212:215], v3 offset:128
    ds_read_b128 v[216:219], v3 offset:192
    ds_read_b128 v[220:223], v3 offset:272
    ds_read_b128 v[224:227], v3 offset:336
    ds_read_b128 v[236:239], v3 offset:400
    ds_read_b128 v[240:243], v3 offset:464
    v_cvt_pk_bf16_f32 v62, v180, v181
    v_cvt_pk_bf16_f32 v63, v182, v183
    v_cvt_pk_bf16_f32 v94, v184, v185
    v_cvt_pk_bf16_f32 v95, v186, v187
    s_waitcnt lgkmcnt(8)
    v_mfma_f32_16x16x32_bf16 v[172:175], v[152:155], v[196:199], v[200:203]
    v_mfma_f32_16x16x32_bf16 v[176:179], v[168:171], v[196:199], v[200:203]
    v_cvt_pk_bf16_f32 v70, v188, v189
    v_cvt_pk_bf16_f32 v71, v190, v191
    v_cvt_pk_bf16_f32 v102, v192, v193
    v_cvt_pk_bf16_f32 v103, v194, v195
    s_mov_b32 s58, 0
    s_mov_b32 s59, s52
    s_mov_b32 s60, s56
    s_add_u32 s61, s56, 6144
    v_cvt_pk_bf16_f32 v78, v172, v173
    v_cvt_pk_bf16_f32 v79, v174, v175
    v_cvt_pk_bf16_f32 v110, v176, v177
    v_cvt_pk_bf16_f32 v111, v178, v179
    s_cmp_lt_u32 s24, 4
    s_cbranch_scc1 L_np
    s_setprio 1
L_np:
    s_cmp_eq_u32 s53, 0
    s_cbranch_scc1 L_epi
L_tile:
    v_add_u32 v11, s60, v4
    s_sub_u32 s62, s54, s58
    v_add_u32 v13, s60, v6
    s_waitcnt vmcnt(4)
    s_cmp_ge_u32 s62, 2
    s_cbranch_scc1 L_dataok
    s_waitcnt vmcnt(2)
    s_cmp_eq_u32 s62, 1
    s_cbranch_scc1 L_dataok
    s_waitcnt vmcnt(0)
L_dataok:
    s_cmp_ge_i32 s59, 16
    s_cbranch_scc1 L_p0
    s_cmp_le_i32 s59, 0
    s_cbranch_scc1 L_p1
    v_cmp_gt_i32 vcc, s59, v1
    v_add_u32 v10, 272, v3
    s_nop 0
    v_cndmask_b32 v10, v10, v3, vcc
    v_cndmask_b32 v12, v11, v5, vcc
    v_cndmask_b32 v11, v5, v11, vcc
    ds_read_b128 v[140:143], v10 offset:0
    ds_read_b128 v[144:147], v10 offset:64
    ds_read_b128 v[148:151], v10 offset:128
    ds_read_b128 v[152:155], v10 offset:192
    ds_read_b128 v[164:167], v12
    ds_read_b128 v[168:171], v12 offset:512
    ds_read_b128 v[156:159], v11
    ds_read_b128 v[160:163], v11 offset:512
    s_waitcnt lgkmcnt(2)
    v_mfma_f32_16x16x32_bf16 v[140:143], v[80:83], v[164:167], v[140:143]
    v_mfma_f32_16x16x32_bf16 v[140:143], v[84:87], v[168:171], v[140:143]
    v_mfma_f32_16x16x32_bf16 v[144:147], v[88:91], v[164:167], v[144:147]
    v_mfma_f32_16x16x32_bf16 v[144:147], v[92:95], v[168:171], v[144:147]
    v_mfma_f32_16x16x32_bf16 v[148:151], v[96:99], v[164:167], v[148:151]
    v_mfma_f32_16x16x32_bf16 v[148:151], v[100:103], v[168:171], v[148:151]
    v_mfma_f32_16x16x32_bf16 v[152:155], v[104:107], v[164:167], v[152:155]
    v_mfma_f32_16x16x32_bf16 v[152:155], v[108:111], v[168:171], v[152:155]
    s_waitcnt lgkmcnt(0)
    v_mfma_f32_16x16x32_bf16 v[140:143], v[48:51], v[156:159], v[140:143]
    v_mfma_f32_16x16x32_bf16 v[140:143], v[52:55], v[160:163], v[140:143]
    v_mfma_f32_16x16x32_bf16 v[144:147], v[56:59], v[156:159], v[144:147]
    v_mfma_f32_16x16x32_bf16 v[144:147], v[60:63], v[160:163], v[144:147]
    v_mfma_f32_16x16x32_bf16 v[148:151], v[64:67], v[156:159], v[148:151]
    v_mfma_f32_16x16x32_bf16 v[148:151], v[68:71], v[160:163], v[148:151]
    v_mfma_f32_16x16x32_bf16 v[152:155], v[72:75], v[156:159], v[152:155]
    v_mfma_f32_16x16x32_bf16 v[152:155], v[76:79], v[160:163], v[152:155]
    s_branch L_fin
L_p0:
    ds_read_b128 v[156:159], v11
    ds_read_b128 v[160:163], v11 offset:512
    s_waitcnt lgkmcnt(0)
    v_mfma_f32_16x16x32_bf16 v[140:143], v[48:51], v[156:159], v[204:207]
    v_mfma_f32_16x16x32_bf16 v[140:143], v[52:55], v[160:163], v[140:143]
    v_mfma_f32_16x16x32_bf16 v[144:147], v[56:59], v[156:159], v[208:211]
    v_mfma_f32_16x16x32_bf16 v[144:147], v[60:63], v[160:163], v[144:147]
    v_mfma_f32_16x16x32_bf16 v[148:151], v[64:67], v[156:159], v[212:215]
    v_mfma_f32_16x16x32_bf16 v[148:151], v[68:71], v[160:163], v[148:151]
    v_mfma_f32_16x16x32_bf16 v[152:155], v[72:75], v[156:159], v[216:219]
    v_mfma_f32_16x16x32_bf16 v[152:155], v[76:79], v[160:163], v[152:155]
    s_branch L_fin
L_p1:
    ds_read_b128 v[156:159], v11
    ds_read_b128 v[160:163], v11 offset:512
    s_waitcnt lgkmcnt(0)
    v_mfma_f32_16x16x32_bf16 v[140:143], v[80:83], v[156:159], v[220:223]
    v_mfma_f32_16x16x32_bf16 v[140:143], v[84:87], v[160:163], v[140:143]
    v_mfma_f32_16x16x32_bf16 v[144:147], v[88:91], v[156:159], v[224:227]
    v_mfma_f32_16x16x32_bf16 v[144:147], v[92:95], v[160:163], v[144:147]
    v_mfma_f32_16x16x32_bf16 v[148:151], v[96:99], v[156:159], v[236:239]
    v_mfma_f32_16x16x32_bf16 v[148:151], v[100:103], v[160:163], v[148:151]
    v_mfma_f32_16x16x32_bf16 v[152:155], v[104:107], v[156:159], v[240:243]
    v_mfma_f32_16x16x32_bf16 v[152:155], v[108:111], v[160:163], v[152:155]
L_fin:
    ds_read_b64_tr_b16 v[172:173], v13 offset:0
    ds_read_b64_tr_b16 v[174:175], v13 offset:256
    ds_read_b64_tr_b16 v[176:177], v13 offset:512
    ds_read_b64_tr_b16 v[178:179], v13 offset:768
    ds_read_b128 v[192:195], v7
    ds_read_u16 v14, v8 offset:1120
    ds_read_u16 v15, v8 offset:1136
    v_exp_f32 v140, v140
    v_exp_f32 v141, v141
    v_exp_f32 v142, v142
    v_exp_f32 v143, v143
    v_add_f32 v140, 1.0, v140
    v_add_f32 v141, 1.0, v141
    v_add_f32 v142, 1.0, v142
    v_add_f32 v143, 1.0, v143
    v_rcp_f32 v140, v140
    v_rcp_f32 v141, v141
    v_rcp_f32 v142, v142
    v_rcp_f32 v143, v143
    v_exp_f32 v144, v144
    v_exp_f32 v145, v145
    v_exp_f32 v146, v146
    v_exp_f32 v147, v147
    v_add_f32 v144, 1.0, v144
    v_add_f32 v145, 1.0, v145
    v_add_f32 v146, 1.0, v146
    v_add_f32 v147, 1.0, v147
    v_cvt_pk_bf16_f32 v180, v140, v141
    v_cvt_pk_bf16_f32 v181, v142, v143
    v_rcp_f32 v144, v144
    v_rcp_f32 v145, v145
    v_rcp_f32 v146, v146
    v_rcp_f32 v147, v147
    v_exp_f32 v148, v148
    v_exp_f32 v149, v149
    v_exp_f32 v150, v150
    v_exp_f32 v151, v151
    v_add_f32 v148, 1.0, v148
    v_add_f32 v149, 1.0, v149
    v_add_f32 v150, 1.0, v150
    v_add_f32 v151, 1.0, v151
    v_cvt_pk_bf16_f32 v182, v144, v145
    v_cvt_pk_bf16_f32 v183, v146, v147
    v_rcp_f32 v148, v148
    v_rcp_f32 v149, v149
    v_mfma_f32_16x16x32_bf16 v[188:191], v[180:183], v[112:115], v[136:139]
    v_rcp_f32 v150, v150
    v_rcp_f32 v151, v151
    v_exp_f32 v152, v152
    v_exp_f32 v153, v153
    v_exp_f32 v154, v154
    v_exp_f32 v155, v155
    v_add_f32 v152, 1.0, v152
    v_add_f32 v153, 1.0, v153
    v_add_f32 v154, 1.0, v154
    v_add_f32 v155, 1.0, v155
    v_cvt_pk_bf16_f32 v184, v148, v149
    v_cvt_pk_bf16_f32 v185, v150, v151
    v_rcp_f32 v152, v152
    v_rcp_f32 v153, v153
    v_rcp_f32 v154, v154
    v_rcp_f32 v155, v155
    s_add_u32 s28, s58, 3
    v_cvt_pk_bf16_f32 v186, v152, v153
    v_cvt_pk_bf16_f32 v187, v154, v155
    v_add_u32 v7, 64, v7
    s_waitcnt lgkmcnt(0)
    v_mfma_f32_16x16x32_bf16 v[188:191], v[184:187], v[116:119], v[188:191]
    s_cmp_ge_u32 s28, s53
    s_cbranch_scc1 L_nopf
    s_mov_b32 m0, s61
    v_add_u32 v14, v14, v2
    v_add_u32 v15, v15, v2
    buffer_load_dwordx4 v14, s[20:23], s30 offen nt lds
    s_add_u32 m0, m0, 1024
    v_add_u32 v8, 32, v8
    buffer_load_dwordx4 v15, s[20:23], s30 offen nt lds
    s_add_u32 s61, s61, 2048
    s_cmp_eq_u32 s28, 4
    s_cselect_b32 s61, s57, s61
L_nopf:
    s_add_u32 s58, s58, 1
    s_sub_u32 s59, s59, 16
    s_add_u32 s60, s60, 2048
    s_cmp_eq_u32 s58, 5
    s_cselect_b32 s60, s57, s60
    s_nop 2
    v_mul_f32 v192, v188, v192
    v_mul_f32 v193, v189, v193
    v_mul_f32 v194, v190, v194
    v_mul_f32 v195, v191, v195
    v_cvt_pk_bf16_f32 v36, v192, v193
    v_cvt_pk_bf16_f32 v37, v194, v195
    s_cmp_lt_u32 s58, s53
    s_nop 0
    v_mfma_f32_16x16x16_bf16 v[120:123], v[172:173], v[36:37], v[120:123]
    v_mfma_f32_16x16x16_bf16 v[124:127], v[174:175], v[36:37], v[124:127]
    v_mfma_f32_16x16x16_bf16 v[128:131], v[176:177], v[36:37], v[128:131]
    v_mfma_f32_16x16x16_bf16 v[132:135], v[178:179], v[36:37], v[132:135]
    s_cbranch_scc1 L_tile
    s_nop 6
L_epi:
    v_cvt_pk_bf16_f32 v140, v120, v121
    v_cvt_pk_bf16_f32 v141, v122, v123
    v_cvt_pk_bf16_f32 v142, v124, v125
    v_cvt_pk_bf16_f32 v143, v126, v127
    v_cndmask_b32 v140, v140, v142, s[46:47]
    v_cndmask_b32 v141, v141, v143, s[46:47]
    v_cvt_pk_bf16_f32 v144, v128, v129
    v_cvt_pk_bf16_f32 v145, v130, v131
    v_cndmask_b32 v140, v140, v144, s[48:49]
    v_cndmask_b32 v141, v141, v145, s[48:49]
    v_cvt_pk_bf16_f32 v146, v132, v133
    v_cvt_pk_bf16_f32 v147, v134, v135
    v_cndmask_b32 v140, v140, v146, s[50:51]
    v_cndmask_b32 v141, v141, v147, s[50:51]
    s_mov_b32 exec_lo, 0x0f0f0f0f
    s_mov_b32 exec_hi, 0x0f0f0f0f
    global_store_dwordx2 v9, v[140:141], s[38:39]
L_end:
    s_endpgm
.section .rodata,"a"
.p2align 6
.amdhsa_kernel standalone__sequential_behavior_din__recsys_kernel
  .amdhsa_next_free_vgpr 248
  .amdhsa_next_free_sgpr 63
  .amdhsa_accum_offset 248
  .amdhsa_group_segment_fixed_size 0
  .amdhsa_kernarg_size 80
  .amdhsa_user_sgpr_count 2
  .amdhsa_user_sgpr_kernarg_segment_ptr 1
  .amdhsa_system_sgpr_workgroup_id_x 1
  .amdhsa_float_denorm_mode_32 3
  .amdhsa_float_denorm_mode_16_64 3
.end_amdhsa_kernel
```
